```python
import torch

def _softmax(x, axis=-1):
    return torch.softmax(x, dim=axis)
def _gelu(x):
    return torch.nn.functional.gelu(x, approximate="tanh")
def _silu(x):
    return torch.nn.functional.silu(x)
def _sigmoid(x):
    return torch.sigmoid(x)
def _layernorm(x, axis=-1, eps=1e-5):
    m = x.mean(dim=axis, keepdim=True)
    v = x.var(dim=axis, keepdim=True, unbiased=False)
    return (x - m) / torch.sqrt(v + eps)
def _scatter_add(tgt, idx, src, axis=0):
    return tgt.clone().index_add_(axis, idx, src)
def _segment_sum(src, seg, n):
    out = torch.zeros((n,) + src.shape[1:], dtype=src.dtype)
    return out.index_add_(0, seg, src)
def _pad(x, pw):
    flat = tuple(v for pair in reversed(pw) for v in pair)
    return torch.nn.functional.pad(x, flat)

kernel_name = 'parallel_sum__gqa_block_cached__glu_gated_bilinear__decode'

def setup_inputs():

    _w = (lambda a: (lambda t: t.to(torch.bfloat16) if t.is_floating_point() else t)(torch.as_tensor(a)))
    def _A_setup():
        B, Sq, D = 4, 1, 512
        Hq, Hkv, Sk, Dh = 32, 8, 4096, 128
        assert Hq % Hkv == 0, (Hq, Hkv)
        return {
            "x": _w((lambda *s: torch.randn(*s, dtype=torch.bfloat16) * 0.05)(B, Sq, D)),
            "k_cache": _w((lambda *s: torch.randn(*s, dtype=torch.bfloat16) * 1.6)(B, Hkv, Sk, Dh)),
            "v_cache": _w((lambda *s: torch.randn(*s, dtype=torch.bfloat16) * 0.8)(B, Hkv, Sk, Dh)),
            "wq": _w((lambda *s: torch.randn(*s, dtype=torch.bfloat16) * 1.6)(D, Hq * Dh) * (D ** -0.5)),
            "wo": _w((lambda *s: torch.randn(*s, dtype=torch.bfloat16) * 0.8)(Hq * Dh, D) * ((Hq * Dh) ** -0.5)),
        }
    _A_in = _A_setup()

    def _B_setup():
        B, S, D, F = 4, 1, 512, 1792
        return {
            "x": _w((lambda *s: torch.randn(*s, dtype=torch.bfloat16) * 0.05)(B, S, D)),
            "w_gate": _w((lambda *s: torch.randn(*s, dtype=torch.bfloat16) * 0.4)(D, F) * (D ** -0.5)),
            "w_up": _w((lambda *s: torch.randn(*s, dtype=torch.bfloat16) * 0.4)(D, F) * (D ** -0.5)),
            "w_down": _w((lambda *s: torch.randn(*s, dtype=torch.bfloat16) * 0.4)(F, D) * (F ** -0.5)),
        }
    _B_in = _B_setup()

    return {
        "A_x": _A_in["x"],
        "A_k_cache": _A_in["k_cache"],
        "A_v_cache": _A_in["v_cache"],
        "A_wq": _A_in["wq"],
        "A_wo": _A_in["wo"],
        "B_x": _B_in["x"],
        "B_w_gate": _B_in["w_gate"],
        "B_w_up": _B_in["w_up"],
        "B_w_down": _B_in["w_down"],
    }

def reference(A_x, A_k_cache, A_v_cache, A_wq, A_wo, B_x, B_w_gate, B_w_up, B_w_down):
    def _A_ref(x, k_cache, v_cache, wq, wo):
        B, Sq, D = x.shape
        Hq, Dh = 32, 128
        Hkv = k_cache.shape[1]
        rep = Hq // Hkv
        q = (lambda x, *d: x.permute(*d))((x @ wq).reshape(B, Sq, Hq, Dh), 0, 2, 1, 3)
        k = (lambda x, n, axis: torch.repeat_interleave(x, n, dim=axis))(k_cache, rep, axis=1)
        v = (lambda x, n, axis: torch.repeat_interleave(x, n, dim=axis))(v_cache, rep, axis=1)
        scores = torch.einsum("bhqd,bhkd->bhqk", q, k) * (Dh ** -0.5)
        p = _softmax(scores, axis=-1)
        o = torch.einsum("bhqk,bhkd->bhqd", p, v)
        return (lambda x, *d: x.permute(*d))(o, 0, 2, 1, 3).reshape(B, Sq, Hq * Dh) @ wo

    def _B_ref(x, w_gate, w_up, w_down):
        g = torch.einsum("bsd,df->bsf", x, w_gate)
        u = torch.einsum("bsd,df->bsf", x, w_up)
        h = g * u
        return torch.einsum("bsf,fd->bsd", h, w_down)

    x = A_x
    xn = _layernorm(x, axis=-1)
    return x + _A_ref(xn, A_k_cache, A_v_cache, A_wq, A_wo) + _B_ref(xn, B_w_gate, B_w_up, B_w_down)
```

```asm
; @launch grid=(256,1,1) block=(1024,1,1) lds=87040
.amdgcn_target "amdgcn-amd-amdhsa--gfx950"
.text
.globl parallel_sum__gqa_block_cached__glu_gated_bilinear__decode_kernel
.p2align 8
.type parallel_sum__gqa_block_cached__glu_gated_bilinear__decode_kernel,@function
parallel_sum__gqa_block_cached__glu_gated_bilinear__decode_kernel:
  s_load_dwordx16 s[16:31], s[0:1], 0
  s_load_dwordx8 s[32:39], s[0:1], 64
  s_cmp_ge_u32 s2, 256
  s_cbranch_scc1 L_exit
  v_lshrrev_b32 v1, 6, v0
  s_lshr_b32 s5, s2, 3
  v_readfirstlane_b32 s3, v1
  s_getpc_b64 s[40:41]
L_pc:
  s_xor_b32 s4, s3, s5
  s_and_b32 s4, s4, 3
  s_cbranch_scc1 L_nopf
  v_lshlrev_b32 v1, 4, v0
  v_min_u32 v1, L_codeend-L_pc-4, v1
  global_load_dword v63, v1, s[40:41]
L_nopf:
  v_and_b32 v0, 63, v0
  s_and_b32 s4, s2, 7
  s_and_b32 s42, s5, 3
  s_lshr_b32 s43, s5, 2
  v_lshrrev_b32 v4, 3, v0
  v_and_b32 v5, 7, v0
  s_and_b32 s14, s2, 0xc4
  s_cmp_gt_u32 s3, 2
  s_cbranch_scc1 L_pro2
  s_setprio 3
  s_cmp_lt_u32 s3, 2
  s_cbranch_scc1 L_early
  s_lshl_b32 s46, s42, 20
  s_lshl_b32 s47, s4, 10
  s_add_u32 s46, s46, s47
  s_lshl_b32 s47, s43, 7
  s_add_u32 s46, s46, s47
  v_lshlrev_b32 v4, 13, v4
  s_mov_b32 m0, 41984
  s_waitcnt lgkmcnt(0)
  s_add_u32 s40, s22, s46
  s_addc_u32 s41, s23, 0
  s_mov_b32 s46, 0x10000
L_dma0:
  v_lshl_add_u32 v4, v5, 4, v4
  s_mov_b32 s48, 16
L_dma:
  global_load_lds_dwordx4 v4, s[40:41] nt
  s_add_u32 s40, s40, s46
  s_addc_u32 s41, s41, 0
  s_add_u32 m0, m0, 1024
  s_sub_u32 s48, s48, 1
  s_cmp_lg_u32 s48, 0
  s_cbranch_scc1 L_dma
L_pro2:
  s_lshr_b32 s6, s5, 3
  s_and_b32 s7, s5, 7
  s_lshl_b32 s8, s6, 3
  s_add_u32 s8, s8, s4
  s_lshl_b32 s8, s8, 3
  s_add_u32 s8, s8, s7
  s_lshl_b32 s9, s8, 17
  s_and_b32 s10, s3, 7
  s_lshl_b32 s11, s10, 14
  s_add_u32 s9, s9, s11
  s_lshl_b32 s11, s3, 1
  s_add_u32 s11, s11, s5
  s_and_b32 s11, s11, 15
  s_lshl_b32 s11, s11, 10
  s_mov_b32 s15, 1048576
  s_mov_b32 s100, 0
  v_mov_b32 v19, 0
  s_cmp_lg_u32 s3, 3
  s_cbranch_scc1 L_bar0
  v_lshlrev_b32 v1, 2, v0
  ds_write_b32 v1, v19
  s_waitcnt lgkmcnt(0)
L_bar0:
  s_barrier
L_bar1:
  s_waitcnt lgkmcnt(0)
  s_cmp_lt_u32 s3, 8
  s_cbranch_scc1 L_kside
  v_lshlrev_b32 v1, 4, v0
  s_add_u32 s68, s20, s9
  s_addc_u32 s69, s21, 0
  s_movk_i32 s70, 0x4000
  s_mov_b32 s71, 0x00020000
  s_xor_b32 s8, s11, 0
  buffer_load_dwordx4 v[64:67], v1, s[68:71], s8 offen nt
  s_xor_b32 s8, s11, 1024
  buffer_load_dwordx4 v[68:71], v1, s[68:71], s8 offen nt
  s_xor_b32 s8, s11, 2048
  buffer_load_dwordx4 v[72:75], v1, s[68:71], s8 offen nt
  s_xor_b32 s8, s11, 3072
  buffer_load_dwordx4 v[76:79], v1, s[68:71], s8 offen nt
  s_xor_b32 s8, s11, 4096
  buffer_load_dwordx4 v[80:83], v1, s[68:71], s8 offen nt
  s_xor_b32 s8, s11, 5120
  buffer_load_dwordx4 v[84:87], v1, s[68:71], s8 offen nt
  s_xor_b32 s8, s11, 6144
  buffer_load_dwordx4 v[88:91], v1, s[68:71], s8 offen nt
  s_xor_b32 s8, s11, 7168
  buffer_load_dwordx4 v[92:95], v1, s[68:71], s8 offen nt
  s_xor_b32 s8, s11, 8192
  buffer_load_dwordx4 v[96:99], v1, s[68:71], s8 offen nt
  s_xor_b32 s8, s11, 9216
  buffer_load_dwordx4 v[100:103], v1, s[68:71], s8 offen nt
  s_xor_b32 s8, s11, 10240
  buffer_load_dwordx4 v[104:107], v1, s[68:71], s8 offen nt
  s_xor_b32 s8, s11, 11264
  buffer_load_dwordx4 v[108:111], v1, s[68:71], s8 offen nt
  s_xor_b32 s8, s11, 12288
  buffer_load_dwordx4 v[112:115], v1, s[68:71], s8 offen nt
  s_xor_b32 s8, s11, 13312
  buffer_load_dwordx4 v[116:119], v1, s[68:71], s8 offen nt
  s_xor_b32 s8, s11, 14336
  buffer_load_dwordx4 v[120:123], v1, s[68:71], s8 offen nt
  s_xor_b32 s8, s11, 15360
  buffer_load_dwordx4 v[124:127], v1, s[68:71], s8 offen nt
  v_mov_b32 v3, 1
  s_mov_b64 exec, 1
  ds_add_u32 v19, v3 offset:64
  s_mov_b64 exec, -1
  v_lshrrev_b32 v2, 4, v0
  v_lshlrev_b32 v2, 7, v2
  v_and_b32 v17, 3, v0
  v_lshl_add_u32 v5, v17, 5, v2
  s_lshl_b32 s40, s10, 9
  v_add_u32 v5, s40, v5
  v_bfe_u32 v8, v0, 2, 2
  v_mul_u32_u24 v4, 544, v17
  v_add_u32 v4, v4, v2
  v_lshl_add_u32 v4, v8, 4, v4
  s_mul_i32 s41, s10, 2176
  v_add_u32 v4, s41, v4
  v_mov_b32 v9, 0x0c0c0c0c
  v_and_b32 v10, 1, v8
  v_lshlrev_b32 v10, 4, v10
  v_mov_b32 v11, 0x0d0c
  v_lshlrev_b32 v11, v10, v11
  v_xor_b32 v11, v9, v11
  v_mov_b32 v12, 0x0f0e
  v_lshlrev_b32 v12, v10, v12
  v_xor_b32 v12, v9, v12
  v_cmp_gt_u32 vcc, 2, v8
  s_nop 1
  v_cndmask_b32 v13, v9, v11, vcc
  v_cndmask_b32 v14, v11, v9, vcc
  v_cndmask_b32 v15, v9, v12, vcc
  v_cndmask_b32 v16, v12, v9, vcc
  s_lshl_b32 s42, s10, 2
  v_mov_b32 v6, s42
L_vwait:
  ds_read_b32 v7, v6 offset:32
  s_waitcnt lgkmcnt(0)
  v_cmp_eq_u32 vcc, 0, v7
  s_cbranch_vccz L_vwaitok
  s_sleep 2
  s_sub_u32 s15, s15, 1
  s_cbranch_scc0 L_vwait
  s_mov_b32 s15, 0
L_vwaitok:
  ds_read_b128 v[24:27], v5 offset:1536
  ds_read_b128 v[28:31], v5 offset:1552
  s_waitcnt vmcnt(16) lgkmcnt(0)
  v_perm_b32 v32, v24, v24, v13
  v_perm_b32 v33, v24, v24, v14
  v_perm_b32 v34, v24, v24, v15
  v_perm_b32 v35, v24, v24, v16
  v_perm_b32 v36, v25, v25, v13
  v_perm_b32 v37, v25, v25, v14
  v_perm_b32 v38, v25, v25, v15
  v_perm_b32 v39, v25, v25, v16
  v_perm_b32 v40, v26, v26, v13
  v_perm_b32 v41, v26, v26, v14
  v_perm_b32 v42, v26, v26, v15
  v_perm_b32 v43, v26, v26, v16
  v_perm_b32 v44, v27, v27, v13
  v_perm_b32 v45, v27, v27, v14
  v_perm_b32 v46, v27, v27, v15
  v_perm_b32 v47, v27, v27, v16
  v_perm_b32 v48, v28, v28, v13
  v_perm_b32 v49, v28, v28, v14
  v_perm_b32 v50, v28, v28, v15
  v_perm_b32 v51, v28, v28, v16
  v_perm_b32 v52, v29, v29, v13
  v_perm_b32 v53, v29, v29, v14
  v_perm_b32 v54, v29, v29, v15
  v_perm_b32 v55, v29, v29, v16
  v_perm_b32 v56, v30, v30, v13
  v_perm_b32 v57, v30, v30, v14
  v_perm_b32 v58, v30, v30, v15
  v_perm_b32 v59, v30, v30, v16
  v_perm_b32 v60, v31, v31, v13
  v_perm_b32 v61, v31, v31, v14
  v_perm_b32 v62, v31, v31, v15
  v_perm_b32 v63, v31, v31, v16
  s_waitcnt vmcnt(15)
  v_mfma_f32_16x16x16_bf16 v[8:11], v[64:65], v[32:33], 0
  v_mfma_f32_16x16x16_bf16 v[12:15], v[66:67], v[32:33], 0
  s_waitcnt vmcnt(14)
  v_mfma_f32_16x16x16_bf16 v[8:11], v[68:69], v[34:35], v[8:11]
  v_mfma_f32_16x16x16_bf16 v[12:15], v[70:71], v[34:35], v[12:15]
  s_waitcnt vmcnt(13)
  v_mfma_f32_16x16x16_bf16 v[8:11], v[72:73], v[36:37], v[8:11]
  v_mfma_f32_16x16x16_bf16 v[12:15], v[74:75], v[36:37], v[12:15]
  s_waitcnt vmcnt(12)
  v_mfma_f32_16x16x16_bf16 v[8:11], v[76:77], v[38:39], v[8:11]
  v_mfma_f32_16x16x16_bf16 v[12:15], v[78:79], v[38:39], v[12:15]
  s_waitcnt vmcnt(11)
  v_mfma_f32_16x16x16_bf16 v[8:11], v[80:81], v[40:41], v[8:11]
  v_mfma_f32_16x16x16_bf16 v[12:15], v[82:83], v[40:41], v[12:15]
  s_waitcnt vmcnt(10)
  v_mfma_f32_16x16x16_bf16 v[8:11], v[84:85], v[42:43], v[8:11]
  v_mfma_f32_16x16x16_bf16 v[12:15], v[86:87], v[42:43], v[12:15]
  s_waitcnt vmcnt(9)
  v_mfma_f32_16x16x16_bf16 v[8:11], v[88:89], v[44:45], v[8:11]
  v_mfma_f32_16x16x16_bf16 v[12:15], v[90:91], v[44:45], v[12:15]
  s_waitcnt vmcnt(8)
  v_mfma_f32_16x16x16_bf16 v[8:11], v[92:93], v[46:47], v[8:11]
  v_mfma_f32_16x16x16_bf16 v[12:15], v[94:95], v[46:47], v[12:15]
  s_waitcnt vmcnt(7)
  v_mfma_f32_16x16x16_bf16 v[8:11], v[96:97], v[48:49], v[8:11]
  v_mfma_f32_16x16x16_bf16 v[12:15], v[98:99], v[48:49], v[12:15]
  s_mov_b64 exec, 1
  ds_add_u32 v19, v3 offset:84
  s_mov_b64 exec, -1
  s_waitcnt vmcnt(6)
  v_mfma_f32_16x16x16_bf16 v[8:11], v[100:101], v[50:51], v[8:11]
  v_mfma_f32_16x16x16_bf16 v[12:15], v[102:103], v[50:51], v[12:15]
  s_waitcnt vmcnt(5)
  v_mfma_f32_16x16x16_bf16 v[8:11], v[104:105], v[52:53], v[8:11]
  v_mfma_f32_16x16x16_bf16 v[12:15], v[106:107], v[52:53], v[12:15]
  s_waitcnt vmcnt(4)
  v_mfma_f32_16x16x16_bf16 v[8:11], v[108:109], v[54:55], v[8:11]
  v_mfma_f32_16x16x16_bf16 v[12:15], v[110:111], v[54:55], v[12:15]
  s_waitcnt vmcnt(3)
  v_mfma_f32_16x16x16_bf16 v[8:11], v[112:113], v[56:57], v[8:11]
  v_mfma_f32_16x16x16_bf16 v[12:15], v[114:115], v[56:57], v[12:15]
  s_waitcnt vmcnt(2)
  v_mfma_f32_16x16x16_bf16 v[8:11], v[116:117], v[58:59], v[8:11]
  v_mfma_f32_16x16x16_bf16 v[12:15], v[118:119], v[58:59], v[12:15]
  s_setprio 3
  s_waitcnt vmcnt(1)
  v_mfma_f32_16x16x16_bf16 v[8:11], v[120:121], v[60:61], v[8:11]
  v_mfma_f32_16x16x16_bf16 v[12:15], v[122:123], v[60:61], v[12:15]
  s_mov_b64 exec, 1
  ds_add_u32 v19, v3 offset:72
  s_mov_b64 exec, -1
  s_waitcnt vmcnt(0)
  v_mfma_f32_16x16x16_bf16 v[8:11], v[124:125], v[62:63], v[8:11]
  v_mfma_f32_16x16x16_bf16 v[12:15], v[126:127], v[62:63], v[12:15]
  s_nop 6
  ds_write_b128 v4, v[8:11] offset:8192
  ds_write_b128 v4, v[12:15] offset:8256
  s_mov_b64 exec, 1
  ds_add_u32 v19, v3 offset:12
L_exit:
  s_endpgm
L_early:
  s_cmp_eq_u32 s3, 0
  s_cbranch_scc1 L_xld
  s_cmp_eq_u32 s14, 0xc4
  s_cbranch_scc1 L_pro2
  s_mul_i32 s54, s4, 3
  s_min_u32 s55, s4, 4
  s_add_u32 s54, s54, s55
  s_lshr_b32 s55, s5, 3
  s_add_u32 s54, s54, s55
  s_and_b32 s55, s43, 1
  s_mul_i32 s46, s42, 458752
  s_lshl_b32 s47, s54, 7
  s_add_u32 s46, s46, s47
  v_mul_u32_u24 v4, 3584, v4
  s_mov_b32 m0, 25600
  s_waitcnt lgkmcnt(0)
  s_cmp_eq_u32 s55, 0
  s_cselect_b32 s40, s28, s30
  s_cselect_b32 s41, s29, s31
  s_add_u32 s40, s40, s46
  s_addc_u32 s41, s41, 0
  s_movk_i32 s46, 28672
  s_branch L_dma0
L_xld:
  v_lshrrev_b32 v1, 4, v0
  v_and_b32 v3, 15, v0
  v_lshlrev_b32 v2, 10, v1
  v_lshl_add_u32 v2, v3, 4, v2
  s_add_u32 s47, s42, 0
  s_and_b32 s47, s47, 3
  s_lshl_b32 s47, s47, 8
  v_add_u32 v6, s47, v2
  s_add_u32 s47, s42, 1
  s_and_b32 s47, s47, 3
  s_lshl_b32 s47, s47, 8
  v_add_u32 v7, s47, v2
  s_add_u32 s47, s42, 2
  s_and_b32 s47, s47, 3
  s_lshl_b32 s47, s47, 8
  v_add_u32 v8, s47, v2
  s_add_u32 s47, s42, 3
  s_and_b32 s47, s47, 3
  s_lshl_b32 s47, s47, 8
  v_add_u32 v9, s47, v2
  s_waitcnt lgkmcnt(0)
  global_load_dwordx4 v[64:67], v6, s[16:17]
  global_load_dwordx4 v[68:71], v7, s[16:17]
  global_load_dwordx4 v[72:75], v8, s[16:17]
  global_load_dwordx4 v[76:79], v9, s[16:17]
  s_branch L_pro2
L_kside:
  s_load_dword s37, s[38:39], 0x40000
  s_cmp_eq_u32 s3, 0
  s_cbranch_scc1 L_ln
  s_cmp_eq_u32 s3, 2
  s_cbranch_scc1 L_tileq
  s_cmp_lg_u32 s3, 1
  s_cbranch_scc1 L_ks2
  s_cmp_lg_u32 s14, 0xc4
  s_cbranch_scc1 L_tileg
L_ks2:
  s_setprio 3
  s_cmp_lt_u32 s3, 4
  s_cbranch_scc1 L_kpart
  s_setprio 2
L_kpart:
  v_bfe_u32 v17, v0, 2, 2
  v_lshlrev_b32 v1, 8, v17
  v_lshrrev_b32 v2, 4, v0
  v_lshl_add_u32 v1, v2, 6, v1
  v_and_b32 v3, 3, v0
  v_lshl_add_u32 v1, v3, 4, v1
  s_add_u32 s68, s18, s9
  s_addc_u32 s69, s19, 0
  s_movk_i32 s70, 0x4000
  s_mov_b32 s71, 0x00020000
  s_xor_b32 s8, s11, 0
  buffer_load_dwordx4 v[64:67], v1, s[68:71], s8 offen nt
  s_xor_b32 s8, s11, 1024
  buffer_load_dwordx4 v[68:71], v1, s[68:71], s8 offen nt
  s_xor_b32 s8, s11, 2048
  buffer_load_dwordx4 v[72:75], v1, s[68:71], s8 offen nt
  s_xor_b32 s8, s11, 3072
  buffer_load_dwordx4 v[76:79], v1, s[68:71], s8 offen nt
  s_xor_b32 s8, s11, 4096
  buffer_load_dwordx4 v[80:83], v1, s[68:71], s8 offen nt
  s_xor_b32 s8, s11, 5120
  buffer_load_dwordx4 v[84:87], v1, s[68:71], s8 offen nt
  s_xor_b32 s8, s11, 6144
  buffer_load_dwordx4 v[88:91], v1, s[68:71], s8 offen nt
  s_xor_b32 s8, s11, 7168
  buffer_load_dwordx4 v[92:95], v1, s[68:71], s8 offen nt
  s_xor_b32 s8, s11, 8192
  buffer_load_dwordx4 v[96:99], v1, s[68:71], s8 offen nt
  s_xor_b32 s8, s11, 9216
  buffer_load_dwordx4 v[100:103], v1, s[68:71], s8 offen nt
  s_xor_b32 s8, s11, 10240
  buffer_load_dwordx4 v[104:107], v1, s[68:71], s8 offen nt
  s_xor_b32 s8, s11, 11264
  buffer_load_dwordx4 v[108:111], v1, s[68:71], s8 offen nt
  s_xor_b32 s8, s11, 12288
  buffer_load_dwordx4 v[112:115], v1, s[68:71], s8 offen nt
  s_xor_b32 s8, s11, 13312
  buffer_load_dwordx4 v[116:119], v1, s[68:71], s8 offen nt
  s_xor_b32 s8, s11, 14336
  buffer_load_dwordx4 v[120:123], v1, s[68:71], s8 offen nt
  s_xor_b32 s8, s11, 15360
  buffer_load_dwordx4 v[124:127], v1, s[68:71], s8 offen nt
  v_lshlrev_b32 v18, 7, v2
  v_lshl_add_u32 v18, v3, 5, v18
  v_lshl_add_u32 v18, v17, 3, v18
  s_lshl_b32 s42, s10, 9
  v_add_u32 v18, s42, v18
  v_lshlrev_b32 v16, 8, v3
  v_lshl_add_u32 v16, v2, 6, v16
  v_lshl_add_u32 v16, v17, 4, v16
  s_lshl_b32 s13, s4, 2
  s_add_u32 s13, s13, s6
  s_waitcnt lgkmcnt(0)
  s_add_u32 s26, s37, 1
  s_and_b32 s96, s26, 0xff
  s_add_u32 s97, s26, 0x35
  s_and_b32 s97, s97, 0xff
  s_add_u32 s98, s26, 0x5a
  s_and_b32 s98, s98, 0xff
  s_add_u32 s99, s26, 0x6f
  s_and_b32 s99, s99, 0xff
  v_mov_b32 v29, 0xffffff00
  s_cmp_lg_u32 s3, 3
  s_cbranch_scc1 L_qw
  v_lshlrev_b32 v20, 4, v0
  v_add_u32 v21, 0x2000, v20
  v_add_u32 v22, 0x4000, v20
  v_add_u32 v23, 0x6000, v20
  s_lshl_b32 s40, s4, 15
  s_lshl_b32 s41, s6, 11
  s_add_u32 s40, s40, s41
  s_add_u32 s40, s38, s40
  s_addc_u32 s41, s39, 0
  s_getreg_b32 s36, hwreg(HW_REG_XCC_ID, 0, 4)
  s_lshl_b32 s44, s36, 7
  s_and_b32 s44, s44, 0x80
  s_xor_b32 s44, s44, s96
  s_lshl_b32 s45, s36, 6
  s_and_b32 s45, s45, 0x80
  s_xor_b32 s45, s45, s97
  s_lshl_b32 s46, s36, 5
  s_and_b32 s46, s46, 0x80
  s_xor_b32 s46, s46, s98
  s_lshl_b32 s47, s36, 4
  s_and_b32 s47, s47, 0x80
  s_xor_b32 s47, s47, s99
  s_mov_b32 s48, 2
  v_mov_b32 v10, 1
L_qpub:
  ds_read_b32 v8, v19 offset:0
  s_waitcnt lgkmcnt(0)
  v_cmp_eq_u32 vcc, 0, v8
  s_cbranch_vccz L_qpubok
  s_sleep 2
  s_sub_u32 s15, s15, 1
  s_cbranch_scc0 L_qpub
  s_mov_b32 s15, 0
L_qpubok:
L_qpoll:
  global_load_dwordx4 v[32:35], v20, s[40:41] offset:0 sc1
  global_load_dwordx4 v[36:39], v20, s[40:41] offset:1024 sc1
  global_load_dwordx4 v[40:43], v21, s[40:41] offset:0 sc1
  global_load_dwordx4 v[44:47], v21, s[40:41] offset:1024 sc1
  global_load_dwordx4 v[48:51], v22, s[40:41] offset:0 sc1
  global_load_dwordx4 v[52:55], v22, s[40:41] offset:1024 sc1
  global_load_dwordx4 v[56:59], v23, s[40:41] offset:0 sc1
  global_load_dwordx4 v[60:63], v23, s[40:41] offset:1024 sc1
  s_waitcnt vmcnt(0)
  v_xor_b32 v32, s44, v32
  v_xor_b32 v33, s45, v33
  v_xor_b32 v34, s46, v34
  v_xor_b32 v35, s47, v35
  v_xor_b32 v36, s44, v36
  v_xor_b32 v37, s45, v37
  v_xor_b32 v38, s46, v38
  v_xor_b32 v39, s47, v39
  v_xor_b32 v40, s44, v40
  v_xor_b32 v41, s45, v41
  v_xor_b32 v42, s46, v42
  v_xor_b32 v43, s47, v43
  v_xor_b32 v44, s44, v44
  v_xor_b32 v45, s45, v45
  v_xor_b32 v46, s46, v46
  v_xor_b32 v47, s47, v47
  v_xor_b32 v48, s44, v48
  v_xor_b32 v49, s45, v49
  v_xor_b32 v50, s46, v50
  v_xor_b32 v51, s47, v51
  v_xor_b32 v52, s44, v52
  v_xor_b32 v53, s45, v53
  v_xor_b32 v54, s46, v54
  v_xor_b32 v55, s47, v55
  v_xor_b32 v56, s44, v56
  v_xor_b32 v57, s45, v57
  v_xor_b32 v58, s46, v58
  v_xor_b32 v59, s47, v59
  v_xor_b32 v60, s44, v60
  v_xor_b32 v61, s45, v61
  v_xor_b32 v62, s46, v62
  v_xor_b32 v63, s47, v63
  v_or3_b32 v9, v32, v33, v34
  v_or3_b32 v9, v9, v35, v36
  v_or3_b32 v9, v9, v37, v38
  v_or3_b32 v9, v9, v39, v40
  v_or3_b32 v9, v9, v41, v42
  v_or3_b32 v9, v9, v43, v44
  v_or3_b32 v9, v9, v45, v46
  v_or3_b32 v9, v9, v47, v48
  v_or3_b32 v9, v9, v49, v50
  v_or3_b32 v9, v9, v51, v52
  v_or3_b32 v9, v9, v53, v54
  v_or3_b32 v9, v9, v55, v56
  v_or3_b32 v9, v9, v57, v58
  v_or3_b32 v9, v9, v59, v60
  v_or3_b32 v9, v9, v61, v62
  v_or_b32 v9, v9, v63
  v_and_b32 v8, 0x7f, v9
  v_cmp_ne_u32 vcc, 0, v8
  s_cbranch_vccz L_qpollok
  s_mov_b64 exec, vcc
  s_sub_u32 s48, s48, 1
  s_cbranch_scc0 L_qpollm
  ds_write_b32 v19, v10 offset:92
  s_sleep 8
L_qpollm:
  s_sub_u32 s15, s15, 1
  s_cbranch_scc0 L_qpoll
  s_mov_b32 s15, 0
L_qpollok:
  s_mov_b64 exec, -1
  v_and_b32 v8, 0x80, v9
  v_cmp_ne_u32 vcc, 0, v8
  v_mov_b32 v8, 0
  s_cbranch_vccz L_samex
  v_and_b32 v32, v29, v32
  v_and_b32 v33, v29, v33
  v_and_b32 v34, v29, v34
  v_and_b32 v35, v29, v35
  v_and_b32 v36, v29, v36
  v_and_b32 v37, v29, v37
  v_and_b32 v38, v29, v38
  v_and_b32 v39, v29, v39
  v_and_b32 v40, v29, v40
  v_and_b32 v41, v29, v41
  v_and_b32 v42, v29, v42
  v_and_b32 v43, v29, v43
  v_and_b32 v44, v29, v44
  v_and_b32 v45, v29, v45
  v_and_b32 v46, v29, v46
  v_and_b32 v47, v29, v47
  v_and_b32 v48, v29, v48
  v_and_b32 v49, v29, v49
  v_and_b32 v50, v29, v50
  v_and_b32 v51, v29, v51
  v_and_b32 v52, v29, v52
  v_and_b32 v53, v29, v53
  v_and_b32 v54, v29, v54
  v_and_b32 v55, v29, v55
  v_and_b32 v56, v29, v56
  v_and_b32 v57, v29, v57
  v_and_b32 v58, v29, v58
  v_and_b32 v59, v29, v59
  v_and_b32 v60, v29, v60
  v_and_b32 v61, v29, v61
  v_and_b32 v62, v29, v62
  v_and_b32 v63, v29, v63
  v_mov_b32 v8, 1
L_samex:
  ds_write_b32 v19, v8 offset:76
  ds_or_b32 v19, v8 offset:92
  v_pk_add_f32 v[32:33], v[32:33], v[40:41]
  v_pk_add_f32 v[48:49], v[48:49], v[56:57]
  v_pk_add_f32 v[34:35], v[34:35], v[42:43]
  v_pk_add_f32 v[50:51], v[50:51], v[58:59]
  v_pk_add_f32 v[36:37], v[36:37], v[44:45]
  v_pk_add_f32 v[52:53], v[52:53], v[60:61]
  v_pk_add_f32 v[38:39], v[38:39], v[46:47]
  v_pk_add_f32 v[54:55], v[54:55], v[62:63]
  v_pk_add_f32 v[32:33], v[32:33], v[48:49]
  v_pk_add_f32 v[34:35], v[34:35], v[50:51]
  v_pk_add_f32 v[36:37], v[36:37], v[52:53]
  v_pk_add_f32 v[38:39], v[38:39], v[54:55]
  v_cvt_pk_bf16_f32 v4, v32, v33
  v_cvt_pk_bf16_f32 v5, v34, v35
  v_cvt_pk_bf16_f32 v6, v36, v37
  v_cvt_pk_bf16_f32 v7, v38, v39
  v_and_b32 v20, 15, v0
  v_lshlrev_b32 v20, 1, v20
  v_lshl_add_u32 v20, v2, 7, v20
  ds_write_b16 v20, v4 offset:512
  ds_write_b16_d16_hi v20, v4 offset:544
  ds_write_b16 v20, v5 offset:576
  ds_write_b16_d16_hi v20, v5 offset:608
  ds_write_b16 v20, v6 offset:1024
  ds_write_b16_d16_hi v20, v6 offset:1056
  ds_write_b16 v20, v7 offset:1088
  ds_write_b16_d16_hi v20, v7 offset:1120
  v_mov_b32 v8, 1
  ds_write_b32 v19, v8 offset:88
  s_branch L_qwok
L_qw:
  ds_read_b64 v[20:21], v19 offset:88
  s_waitcnt lgkmcnt(0)
  v_readfirstlane_b32 s40, v21
  v_cmp_eq_u32 vcc, 0, v20
  s_cmp_eq_u32 s100, 0
  s_cbranch_scc1 L_qw2
  s_cmp_eq_u32 s40, 0
  s_cbranch_scc1 L_qw2
  s_mov_b32 s100, 0
  s_waitcnt vmcnt(0)
  global_store_dwordx4 v7, v[12:15], s[58:59] sc1
L_qw2:
  s_cbranch_vccz L_qwok
  s_sleep 2
  s_sub_u32 s15, s15, 1
  s_cbranch_scc0 L_qw
  s_mov_b32 s15, 0
L_qwok:
  ds_read_b128 v[4:7], v16 offset:512
  s_waitcnt vmcnt(0) lgkmcnt(0)
  v_mfma_f32_16x16x32_bf16 v[8:11], v[64:67], v[4:7], 0
  v_mfma_f32_16x16x32_bf16 v[64:67], v[68:71], v[4:7], 0
  v_mfma_f32_16x16x32_bf16 v[68:71], v[72:75], v[4:7], 0
  v_mfma_f32_16x16x32_bf16 v[72:75], v[76:79], v[4:7], 0
  v_mfma_f32_16x16x32_bf16 v[76:79], v[80:83], v[4:7], 0
  v_mfma_f32_16x16x32_bf16 v[80:83], v[84:87], v[4:7], 0
  v_mfma_f32_16x16x32_bf16 v[84:87], v[88:91], v[4:7], 0
  v_mfma_f32_16x16x32_bf16 v[88:91], v[92:95], v[4:7], 0
  v_mfma_f32_16x16x32_bf16 v[92:95], v[96:99], v[4:7], 0
  v_mfma_f32_16x16x32_bf16 v[96:99], v[100:103], v[4:7], 0
  v_mfma_f32_16x16x32_bf16 v[100:103], v[104:107], v[4:7], 0
  v_mfma_f32_16x16x32_bf16 v[104:107], v[108:111], v[4:7], 0
  v_mfma_f32_16x16x32_bf16 v[108:111], v[112:115], v[4:7], 0
  v_mfma_f32_16x16x32_bf16 v[112:115], v[116:119], v[4:7], 0
  v_mfma_f32_16x16x32_bf16 v[116:119], v[120:123], v[4:7], 0
  v_mfma_f32_16x16x32_bf16 v[120:123], v[124:127], v[4:7], 0
  v_add_f32_dpp v12, v9, v8 row_ror:12 row_mask:0xf bank_mask:0x1
  v_add_f32_dpp v13, v65, v64 row_ror:12 row_mask:0xf bank_mask:0x1
  v_add_f32_dpp v14, v69, v68 row_ror:12 row_mask:0xf bank_mask:0x1
  v_add_f32_dpp v15, v73, v72 row_ror:12 row_mask:0xf bank_mask:0x1
  v_add_f32_dpp v12, v76, v77 row_ror:4 row_mask:0xf bank_mask:0x2
  v_add_f32_dpp v13, v80, v81 row_ror:4 row_mask:0xf bank_mask:0x2
  v_add_f32_dpp v14, v84, v85 row_ror:4 row_mask:0xf bank_mask:0x2
  v_add_f32_dpp v15, v88, v89 row_ror:4 row_mask:0xf bank_mask:0x2
  v_add_f32_dpp v12, v92, v94 row_ror:8 row_mask:0xf bank_mask:0x4
  v_add_f32_dpp v13, v96, v98 row_ror:8 row_mask:0xf bank_mask:0x4
  v_add_f32_dpp v14, v100, v102 row_ror:8 row_mask:0xf bank_mask:0x4
  v_add_f32_dpp v15, v104, v106 row_ror:8 row_mask:0xf bank_mask:0x4
  v_add_f32_dpp v12, v108, v111 row_ror:12 row_mask:0xf bank_mask:0x8
  v_add_f32_dpp v13, v112, v115 row_ror:12 row_mask:0xf bank_mask:0x8
  v_add_f32_dpp v14, v116, v119 row_ror:12 row_mask:0xf bank_mask:0x8
  v_add_f32_dpp v15, v120, v123 row_ror:12 row_mask:0xf bank_mask:0x8
  v_add_f32_dpp v12, v10, v12 row_ror:8 row_mask:0xf bank_mask:0x1
  v_add_f32_dpp v13, v66, v13 row_ror:8 row_mask:0xf bank_mask:0x1
  v_add_f32_dpp v14, v70, v14 row_ror:8 row_mask:0xf bank_mask:0x1
  v_add_f32_dpp v15, v74, v15 row_ror:8 row_mask:0xf bank_mask:0x1
  v_add_f32_dpp v12, v78, v12 row_ror:12 row_mask:0xf bank_mask:0x2
  v_add_f32_dpp v13, v82, v13 row_ror:12 row_mask:0xf bank_mask:0x2
  v_add_f32_dpp v14, v86, v14 row_ror:12 row_mask:0xf bank_mask:0x2
  v_add_f32_dpp v15, v90, v15 row_ror:12 row_mask:0xf bank_mask:0x2
  v_add_f32_dpp v12, v93, v12 row_ror:4 row_mask:0xf bank_mask:0x4
  v_add_f32_dpp v13, v97, v13 row_ror:4 row_mask:0xf bank_mask:0x4
  v_add_f32_dpp v14, v101, v14 row_ror:4 row_mask:0xf bank_mask:0x4
  v_add_f32_dpp v15, v105, v15 row_ror:4 row_mask:0xf bank_mask:0x4
  v_add_f32_dpp v12, v109, v12 row_ror:8 row_mask:0xf bank_mask:0x8
  v_add_f32_dpp v13, v113, v13 row_ror:8 row_mask:0xf bank_mask:0x8
  v_add_f32_dpp v14, v117, v14 row_ror:8 row_mask:0xf bank_mask:0x8
  v_add_f32_dpp v15, v121, v15 row_ror:8 row_mask:0xf bank_mask:0x8
  v_add_f32_dpp v12, v11, v12 row_ror:4 row_mask:0xf bank_mask:0x1
  v_add_f32_dpp v13, v67, v13 row_ror:4 row_mask:0xf bank_mask:0x1
  v_add_f32_dpp v14, v71, v14 row_ror:4 row_mask:0xf bank_mask:0x1
  v_add_f32_dpp v15, v75, v15 row_ror:4 row_mask:0xf bank_mask:0x1
  v_add_f32_dpp v12, v79, v12 row_ror:8 row_mask:0xf bank_mask:0x2
  v_add_f32_dpp v13, v83, v13 row_ror:8 row_mask:0xf bank_mask:0x2
  v_add_f32_dpp v14, v87, v14 row_ror:8 row_mask:0xf bank_mask:0x2
  v_add_f32_dpp v15, v91, v15 row_ror:8 row_mask:0xf bank_mask:0x2
  v_add_f32_dpp v12, v95, v12 row_ror:12 row_mask:0xf bank_mask:0x4
  v_add_f32_dpp v13, v99, v13 row_ror:12 row_mask:0xf bank_mask:0x4
  v_add_f32_dpp v14, v103, v14 row_ror:12 row_mask:0xf bank_mask:0x4
  v_add_f32_dpp v15, v107, v15 row_ror:12 row_mask:0xf bank_mask:0x4
  v_add_f32_dpp v12, v110, v12 row_ror:4 row_mask:0xf bank_mask:0x8
  v_add_f32_dpp v13, v114, v13 row_ror:4 row_mask:0xf bank_mask:0x8
  v_add_f32_dpp v14, v118, v14 row_ror:4 row_mask:0xf bank_mask:0x8
  v_add_f32_dpp v15, v122, v15 row_ror:4 row_mask:0xf bank_mask:0x8
  v_cvt_pk_bf16_f32 v20, v12, v13
  v_cvt_pk_bf16_f32 v21, v14, v15
  v_lshlrev_b32 v12, 16, v20
  v_and_b32 v13, 0xffff0000, v20
  v_lshlrev_b32 v14, 16, v21
  v_and_b32 v15, 0xffff0000, v21
  v_mul_f32 v12, 0x3db504f3, v12
  v_mul_f32 v13, 0x3db504f3, v13
  v_mul_f32 v14, 0x3db504f3, v14
  v_mul_f32 v15, 0x3db504f3, v15
  v_cvt_pk_bf16_f32 v20, v12, v13
  v_cvt_pk_bf16_f32 v21, v14, v15
  v_lshlrev_b32 v12, 16, v20
  v_and_b32 v13, 0xffff0000, v20
  v_lshlrev_b32 v14, 16, v21
  v_and_b32 v15, 0xffff0000, v21
  v_max3_f32 v22, v12, v13, v14
  v_max_f32 v22, v22, v15
  s_nop 1
  v_max_f32_dpp v22, v22, v22 row_ror:4 row_mask:0xf bank_mask:0xf
  s_nop 1
  v_max_f32_dpp v22, v22, v22 row_ror:8 row_mask:0xf bank_mask:0xf
  v_mov_b32 v24, v22
  s_nop 1
  v_permlane16_swap_b32 v22, v24
  v_max_f32 v22, v22, v24
  v_mov_b32 v24, v22
  s_nop 1
  v_permlane32_swap_b32 v22, v24
  v_max_f32 v22, v22, v24
  s_mov_b32 s43, 0x3fb8aa3b
  v_mul_f32 v24, s43, v22
  v_fma_f32 v12, v12, s43, -v24
  v_fma_f32 v13, v13, s43, -v24
  v_fma_f32 v14, v14, s43, -v24
  v_fma_f32 v15, v15, s43, -v24
  v_exp_f32 v12, v12
  v_exp_f32 v13, v13
  v_exp_f32 v14, v14
  v_exp_f32 v15, v15
  v_cvt_pk_bf16_f32 v20, v12, v13
  v_cvt_pk_bf16_f32 v21, v14, v15
  ds_write_b64 v18, v[20:21] offset:1536
  v_add_f32 v23, v12, v13
  v_add_f32 v25, v14, v15
  v_add_f32 v23, v23, v25
  s_nop 1
  v_add_f32_dpp v23, v23, v23 row_ror:4 row_mask:0xf bank_mask:0xf
  s_nop 1
  v_add_f32_dpp v23, v23, v23 row_ror:8 row_mask:0xf bank_mask:0xf
  v_mov_b32 v24, v23
  s_nop 1
  v_permlane16_swap_b32 v23, v24
  v_add_f32 v23, v23, v24
  v_mov_b32 v24, v23
  s_nop 1
  v_permlane32_swap_b32 v23, v24
  v_add_f32 v23, v23, v24
  s_lshl_b32 s42, s10, 3
  v_lshl_add_u32 v24, v3, 6, s42
  ds_write_b64 v24, v[22:23] offset:256
  s_lshl_b32 s42, s10, 2
  v_mov_b32 v26, s42
  v_mov_b32 v27, 1
  ds_write_b32 v26, v27 offset:32
  s_setprio 3
  s_cmp_ge_u32 s3, 4
  s_cbranch_scc1 L_owave
  s_cmp_eq_u32 s3, 2
  s_cbranch_scc1 L_fwave
  s_cmp_lt_u32 s3, 2
  s_cbranch_scc1 L_rwave
  s_lshl_b32 s54, s13, 9
  s_add_u32 s54, s54, 0x44000
  s_add_u32 s54, s38, s54
  s_addc_u32 s55, s39, 0
  v_and_b32 v6, 31, v0
  v_lshlrev_b32 v7, 2, v6
  v_lshlrev_b32 v6, 4, v6
  s_not_b32 s27, s26
L_svi:
  ds_read_b32 v2, v19 offset:64
  s_waitcnt lgkmcnt(0)
  v_cmp_gt_u32 vcc, 3, v2
  s_cbranch_vccz L_sviok
  s_sleep 2
  s_sub_u32 s15, s15, 1
  s_cbranch_scc0 L_svi
  s_mov_b32 s15, 0
L_sviok:
L_spoll:
  global_load_dwordx4 v[40:43], v6, s[54:55] sc1
  s_waitcnt vmcnt(0)
  v_xor_b32 v40, s96, v40
  v_xor_b32 v41, s97, v41
  v_xor_b32 v42, s26, v42
  v_xor_b32 v43, s27, v43
  v_or_b32 v12, v40, v41
  v_and_b32 v12, 0xff, v12
  v_or3_b32 v12, v12, v42, v43
  v_cmp_ne_u32 vcc, 0, v12
  s_cbranch_vccz L_sok
  s_sleep 8
  s_sub_u32 s15, s15, 1
  s_cbranch_scc0 L_spoll
  s_mov_b32 s15, 0
L_sok:
  v_mov_b32 v12, v40
  s_nop 1
  v_max_f32_dpp v12, v12, v12 quad_perm:[1,0,3,2] row_mask:0xf bank_mask:0xf
  s_nop 1
  v_max_f32_dpp v12, v12, v12 quad_perm:[2,3,0,1] row_mask:0xf bank_mask:0xf
  s_nop 1
  v_max_f32_dpp v12, v12, v12 row_half_mirror row_mask:0xf bank_mask:0xf
  v_sub_f32 v12, v40, v12
  v_mul_f32 v12, s43, v12
  v_exp_f32 v12, v12
  s_nop 0
  v_mul_f32 v14, v12, v41
  s_nop 1
  v_add_f32_dpp v14, v14, v14 quad_perm:[1,0,3,2] row_mask:0xf bank_mask:0xf
  s_nop 1
  v_add_f32_dpp v14, v14, v14 quad_perm:[2,3,0,1] row_mask:0xf bank_mask:0xf
  s_nop 1
  v_add_f32_dpp v14, v14, v14 row_half_mirror row_mask:0xf bank_mask:0xf
  v_rcp_f32 v14, v14
  s_nop 0
  v_mul_f32 v12, v12, v14
  ds_write_b32 v7, v12 offset:128
  s_mov_b64 exec, 1
  ds_add_u32 v19, v27 offset:28
  s_endpgm
L_rwave:
  v_and_b32 v1, 7, v0
  v_lshlrev_b32 v1, 2, v1
  v_lshrrev_b32 v3, 5, v0
  s_lshl_b32 s46, s3, 1
  v_add_u32 v3, s46, v3
  v_lshlrev_b32 v4, 6, v3
  v_mul_u32_u24 v5, 544, v3
  v_and_b32 v6, 31, v0
  v_lshl_add_u32 v5, v6, 4, v5
  s_lshl_b32 s46, s4, 5
  s_add_u32 s46, s46, s5
  s_mul_i32 s46, s46, 2304
  s_lshl_b32 s47, s3, 10
  s_add_u32 s46, s46, s47
  s_add_u32 s46, s46, 0x90000
  s_add_u32 s46, s38, s46
  s_addc_u32 s47, s39, 0
  s_lshl_b32 s48, s4, 11
  s_lshl_b32 s49, s5, 4
  s_add_u32 s48, s48, s49
  s_add_u32 s48, s48, 0x44000
  s_add_u32 s48, s38, s48
  s_addc_u32 s49, s39, 0
  v_lshlrev_b32 v7, 4, v0
  v_lshlrev_b32 v6, 9, v3
L_rpf:
  ds_read_b32 v2, v1 offset:32
  s_waitcnt lgkmcnt(0)
  v_cmp_eq_u32 vcc, 0, v2
  s_cbranch_vccz L_rpfok
  s_sleep 2
  s_sub_u32 s15, s15, 1
  s_cbranch_scc0 L_rpf
  s_mov_b32 s15, 0
L_rpfok:
  ds_read_b32 v2, v19 offset:76
  ds_read_b128 v[32:35], v4 offset:256
  ds_read_b128 v[36:39], v4 offset:272
  ds_read_b128 v[40:43], v4 offset:288
  ds_read_b128 v[44:47], v4 offset:304
  s_waitcnt lgkmcnt(0)
  v_readfirstlane_b32 s36, v2
  v_max3_f32 v8, v32, v34, v36
  v_max3_f32 v8, v8, v38, v40
  v_max3_f32 v8, v8, v42, v44
  v_max_f32 v8, v8, v46
  v_sub_f32 v32, v32, v8
  v_sub_f32 v34, v34, v8
  v_sub_f32 v36, v36, v8
  v_sub_f32 v38, v38, v8
  v_sub_f32 v40, v40, v8
  v_sub_f32 v42, v42, v8
  v_sub_f32 v44, v44, v8
  v_sub_f32 v46, v46, v8
  v_mul_f32 v32, s43, v32
  v_mul_f32 v34, s43, v34
  v_mul_f32 v36, s43, v36
  v_mul_f32 v38, s43, v38
  v_mul_f32 v40, s43, v40
  v_mul_f32 v42, s43, v42
  v_mul_f32 v44, s43, v44
  v_mul_f32 v46, s43, v46
  v_exp_f32 v32, v32
  v_exp_f32 v34, v34
  v_exp_f32 v36, v36
  v_exp_f32 v38, v38
  v_exp_f32 v40, v40
  v_exp_f32 v42, v42
  v_exp_f32 v44, v44
  v_exp_f32 v46, v46
  v_mul_f32 v9, v32, v33
  v_fmac_f32 v9, v34, v35
  v_fmac_f32 v9, v36, v37
  v_fmac_f32 v9, v38, v39
  v_fmac_f32 v9, v40, v41
  v_fmac_f32 v9, v42, v43
  v_fmac_f32 v9, v44, v45
  v_fmac_f32 v9, v46, v47
  v_and_or_b32 v8, v8, v29, s96
  v_and_or_b32 v9, v9, v29, s97
  v_mov_b32 v10, s26
  v_not_b32 v11, v10
  s_mov_b32 s52, 1
  s_mov_b32 s53, 1
  s_mov_b64 exec, s[52:53]
  s_cmp_lg_u32 s36, 0
  s_cbranch_scc1 L_rsa
  global_store_dwordx4 v6, v[8:11], s[48:49]
  s_branch L_rsb
L_rsa:
  global_store_dwordx4 v6, v[8:11], s[48:49] sc1
L_rsb:
  s_mov_b64 exec, -1
L_rtk:
  ds_read_b32 v2, v19 offset:72
  s_waitcnt lgkmcnt(0)
  v_cmp_gt_u32 vcc, 8, v2
  s_cbranch_vccz L_rtkok
  s_sleep 1
  s_sub_u32 s15, s15, 1
  s_cbranch_scc0 L_rtk
  s_mov_b32 s15, 0
L_rtkok:
L_rdone:
  ds_read_b32 v2, v19 offset:12
  ds_read_b128 v[64:67], v5 offset:8192
  ds_read_b128 v[68:71], v5 offset:10368
  ds_read_b128 v[72:75], v5 offset:12544
  ds_read_b128 v[76:79], v5 offset:14720
  ds_read_b128 v[80:83], v5 offset:16896
  ds_read_b128 v[84:87], v5 offset:19072
  ds_read_b128 v[88:91], v5 offset:21248
  ds_read_b128 v[92:95], v5 offset:23424
  s_waitcnt lgkmcnt(8)
  v_cmp_gt_u32 vcc, 8, v2
  s_cbranch_vccz L_rdoneok
  s_sub_u32 s15, s15, 1
  s_cbranch_scc0 L_rdone
  s_mov_b32 s15, 0
L_rdoneok:
  s_waitcnt lgkmcnt(7)
  v_pk_mul_f32 v[12:13], v[64:65], v[32:33] op_sel_hi:[1,0]
  v_pk_mul_f32 v[14:15], v[66:67], v[32:33] op_sel_hi:[1,0]
  s_waitcnt lgkmcnt(6)
  v_pk_fma_f32 v[12:13], v[68:69], v[34:35], v[12:13] op_sel_hi:[1,0,1]
  v_pk_fma_f32 v[14:15], v[70:71], v[34:35], v[14:15] op_sel_hi:[1,0,1]
  s_waitcnt lgkmcnt(5)
  v_pk_fma_f32 v[12:13], v[72:73], v[36:37], v[12:13] op_sel_hi:[1,0,1]
  v_pk_fma_f32 v[14:15], v[74:75], v[36:37], v[14:15] op_sel_hi:[1,0,1]
  s_waitcnt lgkmcnt(4)
  v_pk_fma_f32 v[12:13], v[76:77], v[38:39], v[12:13] op_sel_hi:[1,0,1]
  v_pk_fma_f32 v[14:15], v[78:79], v[38:39], v[14:15] op_sel_hi:[1,0,1]
  s_waitcnt lgkmcnt(3)
  v_pk_fma_f32 v[12:13], v[80:81], v[40:41], v[12:13] op_sel_hi:[1,0,1]
  v_pk_fma_f32 v[14:15], v[82:83], v[40:41], v[14:15] op_sel_hi:[1,0,1]
  s_waitcnt lgkmcnt(2)
  v_pk_fma_f32 v[12:13], v[84:85], v[42:43], v[12:13] op_sel_hi:[1,0,1]
  v_pk_fma_f32 v[14:15], v[86:87], v[42:43], v[14:15] op_sel_hi:[1,0,1]
  s_waitcnt lgkmcnt(1)
  v_pk_fma_f32 v[12:13], v[88:89], v[44:45], v[12:13] op_sel_hi:[1,0,1]
  v_pk_fma_f32 v[14:15], v[90:91], v[44:45], v[14:15] op_sel_hi:[1,0,1]
  s_waitcnt lgkmcnt(0)
  v_pk_fma_f32 v[12:13], v[92:93], v[46:47], v[12:13] op_sel_hi:[1,0,1]
  v_pk_fma_f32 v[14:15], v[94:95], v[46:47], v[14:15] op_sel_hi:[1,0,1]
  s_cmp_lg_u32 s36, 0
  v_and_or_b32 v12, v12, v29, s96
  v_and_or_b32 v13, v13, v29, s97
  v_and_or_b32 v14, v14, v29, s98
  v_and_or_b32 v15, v15, v29, s99
  s_cbranch_scc1 L_roa
  global_store_dwordx4 v7, v[12:15], s[46:47]
  s_branch L_rob
L_roa:
  global_store_dwordx4 v7, v[12:15], s[46:47] sc1
L_rob:
  s_mov_b64 exec, 1
  ds_add_u32 v19, v27 offset:28
  s_endpgm
L_owave:
  s_sub_u32 s11, s3, 4
  s_lshl_b32 s12, s13, 2
  s_add_u32 s12, s12, s11
  s_mul_i32 s52, s11, 6144
  s_add_u32 s52, s52, 58368
  v_lshlrev_b32 v11, 5, v2
  v_lshl_add_u32 v11, v3, 3, v11
  v_add_u32 v11, s52, v11
  v_lshl_add_u32 v10, v17, 7, v11
  v_bfe_u32 v34, v0, 2, 1
  v_lshl_add_u32 v11, v34, 11, v11
  v_bfe_u32 v34, v0, 3, 1
  v_lshl_add_u32 v11, v34, 10, v11
  s_lshl_b32 s42, s7, 7
  s_lshl_b32 s46, s12, 15
  s_add_u32 s46, s46, s42
  s_add_u32 s46, s24, s46
  s_addc_u32 s47, s25, 0
  s_add_u32 s44, s32, s42
  s_addc_u32 s45, s33, 0
  v_lshrrev_b32 v4, 3, v0
  v_and_b32 v30, 7, v0
  v_lshlrev_b32 v30, 4, v30
  v_lshl_add_u32 v31, v4, 10, v30
  s_mul_i32 s48, s4, 3
  s_min_u32 s49, s4, 4
  s_add_u32 s48, s48, s49
  s_lshr_b32 s49, s5, 3
  s_add_u32 s48, s48, s49
  s_lshl_b32 s48, s48, 6
  s_lshl_b32 s49, s11, 2
  s_add_u32 s48, s48, s49
  s_cmp_eq_u32 s14, 0xc4
  s_cselect_b32 s48, 0, s48
  v_and_b32 v36, 3, v4
  v_lshrrev_b32 v34, 2, v4
  v_lshl_add_u32 v34, v36, 4, v34
  v_add_u32 v34, s48, v34
  v_lshl_add_u32 v34, v34, 10, v30
  v_add_u32 v35, 2048, v34
  v_bfe_u32 v5, v0, 3, 2
  v_lshrrev_b32 v17, 5, v0
  v_lshlrev_b32 v7, 5, v5
  v_lshl_add_u32 v7, v17, 4, v7
  v_lshlrev_b32 v16, 3, v5
  v_lshl_add_u32 v16, v17, 2, v16
  v_mul_u32_u24 v16, 2304, v16
  v_add_u32 v16, v16, v30
  v_bfe_u32 v4, v0, 2, 3
  v_lshlrev_b32 v4, 2, v4
  v_lshl_add_u32 v4, v3, 5, v4
  v_and_b32 v6, 15, v0
  s_lshl_b32 s49, s11, 7
  v_lshl_add_u32 v6, v6, 3, s49
  v_lshlrev_b32 v18, 4, v0
  v_add_u32 v26, 82944, v18
  s_lshl_b32 s49, s11, 10
  v_add_u32 v27, s49, v26
  v_mov_b32 v1, 1
  v_lshlrev_b32 v12, 7, v0
  v_mov_b32 v13, s26
  v_mov_b32 v56, 0
  v_mov_b32 v57, 0
  v_mov_b32 v58, 0
  v_mov_b32 v59, 0
  v_mov_b32 v60, 0
  v_mov_b32 v61, 0
  v_mov_b32 v62, 0
  v_mov_b32 v63, 0
  s_mov_b32 m0, s52
L_wotk:
  ds_read_b32 v2, v19 offset:84
  s_waitcnt lgkmcnt(0)
  v_cmp_gt_u32 vcc, 8, v2
  s_cbranch_vccz L_wotkok
  s_sleep 2
  s_sub_u32 s15, s15, 1
  s_cbranch_scc0 L_wotk
  s_mov_b32 s15, 0
L_wotkok:
  global_load_lds_dwordx4 v31, s[46:47] nt
  s_add_u32 m0, m0, 1024
  s_add_u32 s46, s46, 8192
  s_addc_u32 s47, s47, 0
  global_load_lds_dwordx4 v31, s[46:47] nt
  s_add_u32 m0, m0, 1024
  s_add_u32 s46, s46, 8192
  s_addc_u32 s47, s47, 0
  global_load_lds_dwordx4 v31, s[46:47] nt
  s_add_u32 m0, m0, 1024
  s_add_u32 s46, s46, 8192
  s_addc_u32 s47, s47, 0
  global_load_lds_dwordx4 v31, s[46:47] nt
  s_add_u32 m0, m0, 1024
  s_cmp_eq_u32 s14, 0xc4
  s_cbranch_scc1 L_nowd
  global_load_lds_dwordx4 v34, s[44:45] nt
  s_add_u32 m0, m0, 1024
  s_nop 0
  global_load_lds_dwordx4 v35, s[44:45] nt
L_nowd:
  s_mul_i32 s44, s4, 73728
  s_and_b32 s45, s12, 15
  s_lshl_b32 s45, s45, 7
  s_add_u32 s44, s44, s45
  s_add_u32 s44, s44, 0x90d80
  s_add_u32 s44, s38, s44
  s_addc_u32 s45, s39, 0
  s_lshl_b32 s46, s7, 5
  s_add_u32 s46, s46, s13
  s_mul_i32 s46, s46, 1280
  s_add_u32 s46, s46, 0x120000
  s_add_u32 s46, s38, s46
  s_addc_u32 s47, s39, 0
  s_lshl_b32 s50, s7, 12
  s_add_u32 s50, s50, s4
  s_add_u32 s50, s50, 0x190000
  s_add_u32 s50, s38, s50
  s_addc_u32 s51, s39, 0
  s_mov_b32 s54, -1
  s_mov_b32 s55, 0
  s_cmp_eq_u32 s6, 0
  s_cselect_b32 s49, 3, 99
L_orp:
  ds_read_b32 v2, v19 offset:28
  s_waitcnt lgkmcnt(0)
  v_cmp_gt_u32 vcc, 4, v2
  s_cbranch_vccz L_orpok
  s_sleep 1
  s_sub_u32 s15, s15, 1
  s_cbranch_scc0 L_orp
  s_mov_b32 s15, 0
L_orpok:
  global_load_dwordx4 v[40:43], v16, s[44:45] offset:-3456 sc1
  global_load_dwordx4 v[44:47], v16, s[44:45] offset:-1152 sc1
  global_load_dwordx4 v[48:51], v16, s[44:45] offset:1152 sc1
  global_load_dwordx4 v[52:55], v16, s[44:45] offset:3456 sc1
  ds_read_b128 v[32:35], v7 offset:128
  ds_read_b64 v[38:39], v6 offset:7168
  s_waitcnt vmcnt(4)
  ds_read_b64_tr_b16 v[64:65], v10 offset:4096
  ds_read_b64_tr_b16 v[66:67], v10 offset:4608
  ds_read_b64_tr_b16 v[68:69], v10 offset:5120
  ds_read_b64_tr_b16 v[70:71], v10 offset:5632
  ds_read_b64_tr_b16 v[96:97], v11 offset:0
  ds_read_b64_tr_b16 v[98:99], v11 offset:128
  ds_read_b64_tr_b16 v[100:101], v11 offset:256
  ds_read_b64_tr_b16 v[102:103], v11 offset:384
  ds_read_b64_tr_b16 v[104:105], v11 offset:512
  ds_read_b64_tr_b16 v[106:107], v11 offset:640
  ds_read_b64_tr_b16 v[108:109], v11 offset:768
  ds_read_b64_tr_b16 v[110:111], v11 offset:896
  s_waitcnt lgkmcnt(8)
  s_cmp_eq_u32 s14, 0xc4
  s_cbranch_scc1 L_ochk
  v_mfma_f32_4x4x4_16b_bf16 v[56:59], v[38:39], v[64:65], v[56:59] cbsz:4 abid:0
  v_mfma_f32_4x4x4_16b_bf16 v[60:63], v[38:39], v[66:67], v[60:63] cbsz:4 abid:1
  s_nop 0
  v_mfma_f32_4x4x4_16b_bf16 v[56:59], v[38:39], v[68:69], v[56:59] cbsz:4 abid:2
  v_mfma_f32_4x4x4_16b_bf16 v[60:63], v[38:39], v[70:71], v[60:63] cbsz:4 abid:3
  s_branch L_ochk
L_opoll:
  global_load_dwordx4 v[40:43], v16, s[44:45] offset:-3456 sc1
  global_load_dwordx4 v[44:47], v16, s[44:45] offset:-1152 sc1
  global_load_dwordx4 v[48:51], v16, s[44:45] offset:1152 sc1
  global_load_dwordx4 v[52:55], v16, s[44:45] offset:3456 sc1
L_ochk:
  s_waitcnt vmcnt(3)
  v_xor_b32 v40, s96, v40
  v_xor_b32 v41, s97, v41
  v_xor_b32 v42, s98, v42
  v_xor_b32 v43, s99, v43
  v_pk_mul_f32 v[20:21], v[40:41], v[32:33] op_sel_hi:[1,0]
  v_pk_mul_f32 v[22:23], v[42:43], v[32:33] op_sel_hi:[1,0]
  v_or3_b32 v28, v40, v41, v42
  v_or_b32 v28, v28, v43
  s_waitcnt vmcnt(2)
  v_xor_b32 v44, s96, v44
  v_xor_b32 v45, s97, v45
  v_xor_b32 v46, s98, v46
  v_xor_b32 v47, s99, v47
  v_pk_fma_f32 v[20:21], v[44:45], v[32:33], v[20:21] op_sel:[0,1,0] op_sel_hi:[1,1,1]
  v_pk_fma_f32 v[22:23], v[46:47], v[32:33], v[22:23] op_sel:[0,1,0] op_sel_hi:[1,1,1]
  v_or3_b32 v28, v28, v44, v45
  v_or3_b32 v28, v28, v46, v47
  s_waitcnt vmcnt(1)
  v_xor_b32 v48, s96, v48
  v_xor_b32 v49, s97, v49
  v_xor_b32 v50, s98, v50
  v_xor_b32 v51, s99, v51
  v_pk_fma_f32 v[20:21], v[48:49], v[34:35], v[20:21] op_sel_hi:[1,0,1]
  v_pk_fma_f32 v[22:23], v[50:51], v[34:35], v[22:23] op_sel_hi:[1,0,1]
  v_or3_b32 v28, v28, v48, v49
  v_or3_b32 v28, v28, v50, v51
  s_waitcnt vmcnt(0)
  v_xor_b32 v52, s96, v52
  v_xor_b32 v53, s97, v53
  v_xor_b32 v54, s98, v54
  v_xor_b32 v55, s99, v55
  v_pk_fma_f32 v[20:21], v[52:53], v[34:35], v[20:21] op_sel:[0,1,0] op_sel_hi:[1,1,1]
  v_pk_fma_f32 v[22:23], v[54:55], v[34:35], v[22:23] op_sel:[0,1,0] op_sel_hi:[1,1,1]
  v_or3_b32 v28, v28, v52, v53
  v_or3_b32 v28, v28, v54, v55
  v_and_b32 v28, 0xff, v28
  v_cmp_ne_u32 vcc, 0, v28
  s_cbranch_vccz L_ook
  s_mov_b64 exec, vcc
  s_sub_u32 s15, s15, 1
  s_cbranch_scc0 L_opoll
  s_mov_b32 s15, 0
L_ook:
  s_mov_b64 exec, 1
  ds_add_rtn_u32 v2, v19, v1 offset:80
  s_mov_b64 exec, -1
  v_permlane32_swap_b32 v20, v21
  v_permlane32_swap_b32 v22, v23
  v_add_f32 v20, v20, v21
  v_add_f32 v22, v22, v23
  v_cvt_pk_bf16_f32 v20, v20, v22
  ds_bpermute_b32 v24, v4, v20
  ds_bpermute_b32 v25, v4, v20 offset:128
  s_waitcnt lgkmcnt(2)
  v_readfirstlane_b32 s48, v2
  s_nop 0
  s_cmp_lg_u32 s48, s49
  s_cbranch_scc1 L_nohint2
  s_mov_b64 exec, s[54:55]
  global_store_byte v12, v13, s[50:51] sc1
  s_mov_b64 exec, -1
L_nohint2:
  s_waitcnt lgkmcnt(0)
  v_mfma_f32_4x4x4_16b_bf16 v[56:59], v[24:25], v[96:97], v[56:59] cbsz:4 abid:0
  v_mfma_f32_4x4x4_16b_bf16 v[60:63], v[24:25], v[98:99], v[60:63] cbsz:4 abid:1
  s_nop 0
  v_mfma_f32_4x4x4_16b_bf16 v[56:59], v[24:25], v[100:101], v[56:59] cbsz:4 abid:2
  v_mfma_f32_4x4x4_16b_bf16 v[60:63], v[24:25], v[102:103], v[60:63] cbsz:4 abid:3
  s_nop 0
  v_mfma_f32_4x4x4_16b_bf16 v[56:59], v[24:25], v[104:105], v[56:59] cbsz:4 abid:4
  v_mfma_f32_4x4x4_16b_bf16 v[60:63], v[24:25], v[106:107], v[60:63] cbsz:4 abid:5
  s_nop 0
  v_mfma_f32_4x4x4_16b_bf16 v[56:59], v[24:25], v[108:109], v[56:59] cbsz:4 abid:6
  v_mfma_f32_4x4x4_16b_bf16 v[60:63], v[24:25], v[110:111], v[60:63] cbsz:4 abid:7
  s_nop 4
  v_pk_add_f32 v[56:57], v[56:57], v[60:61]
  v_pk_add_f32 v[58:59], v[58:59], v[62:63]
  ds_write_b128 v27, v[56:59]
  s_mov_b64 exec, 1
  ds_add_rtn_u32 v2, v19, v1 offset:20
  s_mov_b64 exec, -1
  ds_read_b128 v[112:115], v26 offset:0
  ds_read_b128 v[116:119], v26 offset:1024
  ds_read_b128 v[120:123], v26 offset:2048
  ds_read_b128 v[124:127], v26 offset:3072
  s_waitcnt lgkmcnt(4)
  v_readfirstlane_b32 s48, v2
  s_nop 0
  s_cmp_lg_u32 s48, 3
  s_cbranch_scc1 L_exit
  s_waitcnt lgkmcnt(2)
  v_pk_add_f32 v[112:113], v[112:113], v[116:117]
  v_pk_add_f32 v[114:115], v[114:115], v[118:119]
  s_waitcnt lgkmcnt(0)
  v_pk_add_f32 v[120:121], v[120:121], v[124:125]
  v_pk_add_f32 v[122:123], v[122:123], v[126:127]
  v_pk_add_f32 v[112:113], v[112:113], v[120:121]
  v_pk_add_f32 v[114:115], v[114:115], v[122:123]
  v_and_or_b32 v112, v112, v29, s96
  v_and_or_b32 v113, v113, v29, s97
  v_and_or_b32 v114, v114, v29, s98
  v_and_or_b32 v115, v115, v29, s99
  global_store_dwordx4 v18, v[112:115], s[46:47] sc1
  ds_write_b32 v19, v1 offset:8
  s_endpgm
L_fwave:
  s_lshl_b32 s40, s13, 13
  s_add_u32 s40, s40, 0x49000
  s_add_u32 s40, s38, s40
  s_addc_u32 s41, s39, 0
  v_lshlrev_b32 v20, 4, v0
  s_lshl_b32 s44, s4, 7
  s_lshl_b32 s45, s5, 2
  s_add_u32 s44, s44, s45
  v_and_b32 v3, 1, v0
  v_lshl_add_u32 v4, v3, 1, s44
  v_bfe_u32 v5, v0, 4, 1
  v_lshl_add_u32 v4, v5, 11, v4
  v_lshrrev_b32 v5, 5, v0
  v_lshl_add_u32 v4, v5, 10, v4
  global_load_ushort v6, v4, s[16:17]
  s_cmp_eq_u32 s14, 0xc4
  s_cbranch_scc1 L_noh
L_hpoll:
  global_load_dwordx4 v[32:35], v20, s[40:41] offset:-4096 sc1
  global_load_dwordx4 v[36:39], v20, s[40:41] offset:-3072 sc1
  global_load_dwordx4 v[40:43], v20, s[40:41] offset:-2048 sc1
  global_load_dwordx4 v[44:47], v20, s[40:41] offset:-1024 sc1
  global_load_dwordx4 v[48:51], v20, s[40:41] offset:0 sc1
  global_load_dwordx4 v[52:55], v20, s[40:41] offset:1024 sc1
  global_load_dwordx4 v[56:59], v20, s[40:41] offset:2048 sc1
  global_load_dwordx4 v[60:63], v20, s[40:41] offset:3072 sc1
  s_waitcnt vmcnt(0)
  v_xor_b32 v32, s96, v32
  v_xor_b32 v33, s97, v33
  v_xor_b32 v34, s98, v34
  v_xor_b32 v35, s99, v35
  v_xor_b32 v36, s96, v36
  v_xor_b32 v37, s97, v37
  v_xor_b32 v38, s98, v38
  v_xor_b32 v39, s99, v39
  v_xor_b32 v40, s96, v40
  v_xor_b32 v41, s97, v41
  v_xor_b32 v42, s98, v42
  v_xor_b32 v43, s99, v43
  v_xor_b32 v44, s96, v44
  v_xor_b32 v45, s97, v45
  v_xor_b32 v46, s98, v46
  v_xor_b32 v47, s99, v47
  v_xor_b32 v48, s96, v48
  v_xor_b32 v49, s97, v49
  v_xor_b32 v50, s98, v50
  v_xor_b32 v51, s99, v51
  v_xor_b32 v52, s96, v52
  v_xor_b32 v53, s97, v53
  v_xor_b32 v54, s98, v54
  v_xor_b32 v55, s99, v55
  v_xor_b32 v56, s96, v56
  v_xor_b32 v57, s97, v57
  v_xor_b32 v58, s98, v58
  v_xor_b32 v59, s99, v59
  v_xor_b32 v60, s96, v60
  v_xor_b32 v61, s97, v61
  v_xor_b32 v62, s98, v62
  v_xor_b32 v63, s99, v63
  v_or3_b32 v9, v32, v33, v34
  v_or3_b32 v9, v9, v35, v36
  v_or3_b32 v9, v9, v37, v38
  v_or3_b32 v9, v9, v39, v40
  v_or3_b32 v9, v9, v41, v42
  v_or3_b32 v9, v9, v43, v44
  v_or3_b32 v9, v9, v45, v46
  v_or3_b32 v9, v9, v47, v48
  v_or3_b32 v9, v9, v49, v50
  v_or3_b32 v9, v9, v51, v52
  v_or3_b32 v9, v9, v53, v54
  v_or3_b32 v9, v9, v55, v56
  v_or3_b32 v9, v9, v57, v58
  v_or3_b32 v9, v9, v59, v60
  v_or3_b32 v9, v9, v61, v62
  v_or_b32 v9, v9, v63
  v_and_b32 v8, 0xff, v9
  v_cmp_ne_u32 vcc, 0, v8
  s_cbranch_vccz L_hpollok
  s_mov_b64 exec, vcc
  s_sleep 8
  s_sub_u32 s15, s15, 1
  s_cbranch_scc0 L_hpoll
  s_mov_b32 s15, 0
L_hpollok:
  s_mov_b64 exec, -1
  v_pk_add_f32 v[32:33], v[32:33], v[40:41]
  v_pk_add_f32 v[48:49], v[48:49], v[56:57]
  v_pk_add_f32 v[34:35], v[34:35], v[42:43]
  v_pk_add_f32 v[50:51], v[50:51], v[58:59]
  v_pk_add_f32 v[36:37], v[36:37], v[44:45]
  v_pk_add_f32 v[52:53], v[52:53], v[60:61]
  v_pk_add_f32 v[38:39], v[38:39], v[46:47]
  v_pk_add_f32 v[54:55], v[54:55], v[62:63]
  v_pk_add_f32 v[32:33], v[32:33], v[48:49]
  v_pk_add_f32 v[34:35], v[34:35], v[50:51]
  v_pk_add_f32 v[36:37], v[36:37], v[52:53]
  v_pk_add_f32 v[38:39], v[38:39], v[54:55]
  v_cvt_pk_bf16_f32 v8, v32, v33
  v_cvt_pk_bf16_f32 v9, v34, v35
  v_lshlrev_b32 v32, 16, v8
  v_and_b32 v33, 0xffff0000, v8
  v_lshlrev_b32 v34, 16, v9
  v_and_b32 v35, 0xffff0000, v9
  v_cvt_pk_bf16_f32 v8, v36, v37
  v_cvt_pk_bf16_f32 v9, v38, v39
  v_lshlrev_b32 v36, 16, v8
  v_and_b32 v37, 0xffff0000, v8
  v_lshlrev_b32 v38, 16, v9
  v_and_b32 v39, 0xffff0000, v9
  v_pk_mul_f32 v[32:33], v[32:33], v[36:37]
  v_pk_mul_f32 v[34:35], v[34:35], v[38:39]
  v_cvt_pk_bf16_f32 v32, v32, v33
  v_cvt_pk_bf16_f32 v33, v34, v35
  v_and_b32 v21, 15, v0
  v_lshlrev_b32 v21, 5, v21
  v_lshl_add_u32 v21, v2, 3, v21
  ds_write_b64 v21, v[32:33] offset:7168
L_noh:
  s_mov_b64 exec, 1
  ds_add_u32 v19, v27 offset:28
  s_mov_b64 exec, -1
  s_waitcnt vmcnt(0)
  v_lshlrev_b32 v6, 16, v6
  v_lshrrev_b32 v8, 1, v0
  v_mul_u32_u24 v8, 1280, v8
  v_lshl_add_u32 v8, v3, 4, v8
  s_mul_i32 s46, s4, 40960
  s_lshl_b32 s47, s5, 5
  s_add_u32 s46, s46, s47
  s_add_u32 s46, s46, 0x120000
  s_add_u32 s46, s38, s46
  s_addc_u32 s47, s39, 0
  s_mov_b32 s48, 0x00030003
  s_mov_b32 s49, 0x00030003
  v_mov_b32 v12, 0x40000
  v_mov_b32 v13, s26
  s_lshl_b32 s50, s4, 5
  s_add_u32 s50, s50, s5
  s_lshl_b32 s50, s50, 7
  s_add_u32 s50, s50, 0x190000
  s_add_u32 s50, s38, s50
  s_addc_u32 s51, s39, 0
  s_mul_i32 s66, s96, 0x01010101
  s_mov_b32 s67, s66
L_frp:
  ds_read_b32 v2, v19 offset:80
  s_waitcnt lgkmcnt(0)
  v_cmp_gt_u32 vcc, 4, v2
  s_cbranch_vccz L_frpok
  s_sleep 1
  s_sub_u32 s15, s15, 1
  s_cbranch_scc0 L_frp
  s_mov_b32 s15, 0
L_frpok:
L_hw2:
  s_load_dwordx2 s[56:57], s[50:51], 0 glc
  ds_read_b32 v2, v19 offset:8
  s_waitcnt lgkmcnt(0)
  v_cmp_eq_u32 vcc, 0, v2
  s_cmp_lg_u64 s[56:57], s[66:67]
  s_cbranch_scc0 L_hw2ok
  s_sub_u32 s15, s15, 1
  s_cbranch_scc0 L_hw2
  s_mov_b32 s15, 0
L_hw2ok:
  s_cbranch_vccz L_fodok
L_fod:
  ds_read_b32 v2, v19 offset:8
  s_waitcnt lgkmcnt(0)
  v_cmp_eq_u32 vcc, 0, v2
  s_cbranch_vccz L_fodok
  s_sub_u32 s15, s15, 1
  s_cbranch_scc0 L_fod
  s_mov_b32 s15, 0
L_fodok:
L_fpoll:
  global_load_dwordx4 v[20:23], v8, s[46:47] sc0 sc1
  s_waitcnt vmcnt(0)
  v_xor_b32 v20, s96, v20
  v_xor_b32 v21, s97, v21
  v_xor_b32 v22, s98, v22
  v_xor_b32 v23, s99, v23
  v_or3_b32 v28, v20, v21, v22
  v_or_b32 v28, v28, v23
  v_and_b32 v28, 0xff, v28
  v_cmp_ne_u32 vcc, 0, v28
  s_cbranch_vccz L_fok
  s_mov_b64 exec, vcc
  s_sub_u32 s15, s15, 1
  s_cbranch_scc0 L_fpoll
  s_mov_b32 s15, 0
L_fok:
  s_mov_b64 exec, -1
  v_permlane32_swap_b32 v20, v21
  v_permlane32_swap_b32 v22, v23
  v_add_f32 v20, v20, v21
  v_add_f32 v22, v22, v23
  s_nop 1
  v_permlane16_swap_b32 v20, v22
  v_add_f32 v20, v20, v22
  s_nop 1
  v_add_f32_dpp v20, v20, v20 row_ror:2 row_mask:0xf bank_mask:0xf
  s_nop 1
  v_add_f32_dpp v20, v20, v20 row_ror:4 row_mask:0xf bank_mask:0xf
  s_nop 1
  v_add_f32_dpp v20, v20, v20 row_ror:8 row_mask:0xf bank_mask:0xf
  v_add_f32 v20, v20, v6
  v_cvt_pk_bf16_f32 v20, v20, v20
  s_mov_b64 exec, s[48:49]
  global_store_short v4, v20, s[34:35]
  s_cmp_lg_u32 s2, 0
  s_cbranch_scc1 L_fend
  s_mov_b64 exec, 1
  global_store_dword v12, v13, s[38:39]
L_fend:
  s_endpgm
L_ln:
  s_waitcnt vmcnt(0)
  v_lshlrev_b32 v80, 16, v64
  v_and_b32 v81, 0xffff0000, v64
  v_lshlrev_b32 v82, 16, v65
  v_and_b32 v83, 0xffff0000, v65
  v_lshlrev_b32 v84, 16, v66
  v_and_b32 v85, 0xffff0000, v66
  v_lshlrev_b32 v86, 16, v67
  v_and_b32 v87, 0xffff0000, v67
  v_lshlrev_b32 v88, 16, v68
  v_and_b32 v89, 0xffff0000, v68
  v_lshlrev_b32 v90, 16, v69
  v_and_b32 v91, 0xffff0000, v69
  v_lshlrev_b32 v92, 16, v70
  v_and_b32 v93, 0xffff0000, v70
  v_lshlrev_b32 v94, 16, v71
  v_and_b32 v95, 0xffff0000, v71
  v_lshlrev_b32 v96, 16, v72
  v_and_b32 v97, 0xffff0000, v72
  v_lshlrev_b32 v98, 16, v73
  v_and_b32 v99, 0xffff0000, v73
  v_lshlrev_b32 v100, 16, v74
  v_and_b32 v101, 0xffff0000, v74
  v_lshlrev_b32 v102, 16, v75
  v_and_b32 v103, 0xffff0000, v75
  v_lshlrev_b32 v104, 16, v76
  v_and_b32 v105, 0xffff0000, v76
  v_lshlrev_b32 v106, 16, v77
  v_and_b32 v107, 0xffff0000, v77
  v_lshlrev_b32 v108, 16, v78
  v_and_b32 v109, 0xffff0000, v78
  v_lshlrev_b32 v110, 16, v79
  v_and_b32 v111, 0xffff0000, v79
  v_pk_add_f32 v[20:21], v[80:81], v[82:83]
  v_pk_add_f32 v[22:23], v[84:85], v[86:87]
  v_pk_add_f32 v[20:21], v[20:21], v[88:89]
  v_pk_add_f32 v[22:23], v[22:23], v[90:91]
  v_pk_add_f32 v[20:21], v[20:21], v[92:93]
  v_pk_add_f32 v[22:23], v[22:23], v[94:95]
  v_pk_add_f32 v[20:21], v[20:21], v[96:97]
  v_pk_add_f32 v[22:23], v[22:23], v[98:99]
  v_pk_add_f32 v[20:21], v[20:21], v[100:101]
  v_pk_add_f32 v[22:23], v[22:23], v[102:103]
  v_pk_add_f32 v[20:21], v[20:21], v[104:105]
  v_pk_add_f32 v[22:23], v[22:23], v[106:107]
  v_pk_add_f32 v[20:21], v[20:21], v[108:109]
  v_pk_add_f32 v[22:23], v[22:23], v[110:111]
  v_pk_add_f32 v[20:21], v[20:21], v[22:23]
  v_add_f32 v20, v20, v21
  s_nop 1
  v_add_f32_dpp v20, v20, v20 row_ror:8 row_mask:0xf bank_mask:0xf
  s_nop 1
  v_add_f32_dpp v20, v20, v20 row_ror:4 row_mask:0xf bank_mask:0xf
  s_nop 1
  v_add_f32_dpp v20, v20, v20 row_ror:2 row_mask:0xf bank_mask:0xf
  s_nop 1
  v_add_f32_dpp v20, v20, v20 row_ror:1 row_mask:0xf bank_mask:0xf
  v_mul_f32 v20, 0x3b000000, v20
  v_cvt_pk_bf16_f32 v22, v20, v20
  v_lshlrev_b32 v22, 16, v22
  v_sub_f32 v24, v20, v22
  v_pk_add_f32 v[80:81], v[80:81], v[22:23] op_sel_hi:[1,0] neg_lo:[0,1] neg_hi:[0,1]
  v_pk_add_f32 v[82:83], v[82:83], v[22:23] op_sel_hi:[1,0] neg_lo:[0,1] neg_hi:[0,1]
  v_pk_add_f32 v[84:85], v[84:85], v[22:23] op_sel_hi:[1,0] neg_lo:[0,1] neg_hi:[0,1]
  v_pk_add_f32 v[86:87], v[86:87], v[22:23] op_sel_hi:[1,0] neg_lo:[0,1] neg_hi:[0,1]
  v_pk_add_f32 v[88:89], v[88:89], v[22:23] op_sel_hi:[1,0] neg_lo:[0,1] neg_hi:[0,1]
  v_pk_add_f32 v[90:91], v[90:91], v[22:23] op_sel_hi:[1,0] neg_lo:[0,1] neg_hi:[0,1]
  v_pk_add_f32 v[92:93], v[92:93], v[22:23] op_sel_hi:[1,0] neg_lo:[0,1] neg_hi:[0,1]
  v_pk_add_f32 v[94:95], v[94:95], v[22:23] op_sel_hi:[1,0] neg_lo:[0,1] neg_hi:[0,1]
  v_pk_add_f32 v[96:97], v[96:97], v[22:23] op_sel_hi:[1,0] neg_lo:[0,1] neg_hi:[0,1]
  v_pk_add_f32 v[98:99], v[98:99], v[22:23] op_sel_hi:[1,0] neg_lo:[0,1] neg_hi:[0,1]
  v_pk_add_f32 v[100:101], v[100:101], v[22:23] op_sel_hi:[1,0] neg_lo:[0,1] neg_hi:[0,1]
  v_pk_add_f32 v[102:103], v[102:103], v[22:23] op_sel_hi:[1,0] neg_lo:[0,1] neg_hi:[0,1]
  v_pk_add_f32 v[104:105], v[104:105], v[22:23] op_sel_hi:[1,0] neg_lo:[0,1] neg_hi:[0,1]
  v_pk_add_f32 v[106:107], v[106:107], v[22:23] op_sel_hi:[1,0] neg_lo:[0,1] neg_hi:[0,1]
  v_pk_add_f32 v[108:109], v[108:109], v[22:23] op_sel_hi:[1,0] neg_lo:[0,1] neg_hi:[0,1]
  v_pk_add_f32 v[110:111], v[110:111], v[22:23] op_sel_hi:[1,0] neg_lo:[0,1] neg_hi:[0,1]
  v_pk_mul_f32 v[26:27], v[80:81], v[80:81]
  v_pk_mul_f32 v[28:29], v[82:83], v[82:83]
  v_pk_fma_f32 v[26:27], v[84:85], v[84:85], v[26:27]
  v_pk_fma_f32 v[28:29], v[86:87], v[86:87], v[28:29]
  v_pk_fma_f32 v[26:27], v[88:89], v[88:89], v[26:27]
  v_pk_fma_f32 v[28:29], v[90:91], v[90:91], v[28:29]
  v_pk_fma_f32 v[26:27], v[92:93], v[92:93], v[26:27]
  v_pk_fma_f32 v[28:29], v[94:95], v[94:95], v[28:29]
  v_pk_fma_f32 v[26:27], v[96:97], v[96:97], v[26:27]
  v_pk_fma_f32 v[28:29], v[98:99], v[98:99], v[28:29]
  v_pk_fma_f32 v[26:27], v[100:101], v[100:101], v[26:27]
  v_pk_fma_f32 v[28:29], v[102:103], v[102:103], v[28:29]
  v_pk_fma_f32 v[26:27], v[104:105], v[104:105], v[26:27]
  v_pk_fma_f32 v[28:29], v[106:107], v[106:107], v[28:29]
  v_pk_fma_f32 v[26:27], v[108:109], v[108:109], v[26:27]
  v_pk_fma_f32 v[28:29], v[110:111], v[110:111], v[28:29]
  v_pk_add_f32 v[26:27], v[26:27], v[28:29]
  v_add_f32 v26, v26, v27
  s_nop 1
  v_add_f32_dpp v26, v26, v26 row_ror:8 row_mask:0xf bank_mask:0xf
  s_nop 1
  v_add_f32_dpp v26, v26, v26 row_ror:4 row_mask:0xf bank_mask:0xf
  s_nop 1
  v_add_f32_dpp v26, v26, v26 row_ror:2 row_mask:0xf bank_mask:0xf
  s_nop 1
  v_add_f32_dpp v26, v26, v26 row_ror:1 row_mask:0xf bank_mask:0xf
  v_mul_f32 v26, 0x3b000000, v26
  v_fma_f32 v26, -v24, v24, v26
  v_max_f32 v26, 0, v26
  v_cvt_pk_bf16_f32 v26, v26, v26
  v_lshlrev_b32 v26, 16, v26
  v_add_f32 v26, 0x3727c5ac, v26
  v_cvt_pk_bf16_f32 v26, v26, v26
  v_lshlrev_b32 v26, 16, v26
  v_sqrt_f32 v26, v26
  s_nop 0
  v_cvt_pk_bf16_f32 v26, v26, v26
  v_lshlrev_b32 v26, 16, v26
  v_rcp_f32 v26, v26
  v_cvt_pk_bf16_f32 v64, v80, v81
  v_cvt_pk_bf16_f32 v65, v82, v83
  v_lshlrev_b32 v80, 16, v64
  v_and_b32 v81, 0xffff0000, v64
  v_lshlrev_b32 v82, 16, v65
  v_and_b32 v83, 0xffff0000, v65
  v_cvt_pk_bf16_f32 v66, v84, v85
  v_cvt_pk_bf16_f32 v67, v86, v87
  v_lshlrev_b32 v84, 16, v66
  v_and_b32 v85, 0xffff0000, v66
  v_lshlrev_b32 v86, 16, v67
  v_and_b32 v87, 0xffff0000, v67
  v_pk_mul_f32 v[80:81], v[80:81], v[26:27] op_sel_hi:[1,0]
  v_pk_mul_f32 v[82:83], v[82:83], v[26:27] op_sel_hi:[1,0]
  v_pk_mul_f32 v[84:85], v[84:85], v[26:27] op_sel_hi:[1,0]
  v_pk_mul_f32 v[86:87], v[86:87], v[26:27] op_sel_hi:[1,0]
  v_cvt_pk_bf16_f32 v20, v80, v81
  v_cvt_pk_bf16_f32 v21, v82, v83
  v_cvt_pk_bf16_f32 v22, v84, v85
  v_cvt_pk_bf16_f32 v23, v86, v87
  v_lshlrev_b32 v2, 4, v0
  ds_write_b128 v2, v[20:23] offset:6144
  v_mov_b32 v1, 1
  ds_write_b32 v19, v1 offset:24
  s_branch L_kpart
L_tileg:
  v_lshlrev_b32 v7, 4, v0
  v_lshrrev_b32 v1, 4, v0
  s_lshl_b32 s58, s4, 2
  s_add_u32 s58, s58, s6
  s_lshl_b32 s58, s58, 3
  s_lshl_b32 s57, s42, 1
  s_add_u32 s58, s58, s57
  s_add_u32 s58, s58, s55
  s_lshl_b32 s58, s58, 10
  s_add_u32 s58, s58, 0x48000
  s_movk_i32 s45, 25600
  v_mov_b32 v10, 16
  s_branch L_tile
L_tileq:
  v_and_b32 v3, 15, v0
  v_lshrrev_b32 v1, 4, v0
  v_lshlrev_b32 v7, 11, v1
  v_lshl_add_u32 v7, v3, 4, v7
  s_lshl_b32 s58, s4, 15
  s_lshl_b32 s53, s42, 13
  s_add_u32 s58, s58, s53
  s_lshl_b32 s53, s43, 8
  s_add_u32 s58, s58, s53
  s_mov_b32 s45, 41984
  v_mov_b32 v10, 0
L_tile:
  v_lshrrev_b32 v4, 2, v0
  v_lshlrev_b32 v4, 7, v4
  v_and_b32 v5, 3, v0
  v_lshl_add_u32 v4, v5, 3, v4
  v_add_u32 v4, s45, v4
  v_bfe_u32 v8, v0, 2, 2
  v_lshlrev_b32 v6, 8, v8
  v_lshl_add_u32 v6, v1, 3, v6
  v_add_u32 v6, 6144, v6
  s_add_u32 s58, s38, s58
  s_addc_u32 s59, s39, 0
  v_mov_b32 v11, 1
  s_waitcnt lgkmcnt(0)
  s_add_u32 s26, s37, 1
  s_and_b32 s96, s26, 0xff
  s_add_u32 s97, s26, 0x35
  s_and_b32 s97, s97, 0xff
  s_add_u32 s98, s26, 0x5a
  s_and_b32 s98, s98, 0xff
  s_add_u32 s99, s26, 0x6f
  s_and_b32 s99, s99, 0xff
  v_mov_b32 v29, 0xffffff00
  s_getreg_b32 s36, hwreg(HW_REG_XCC_ID, 0, 4)
  s_cmp_eq_u32 s3, 2
  s_cselect_b32 s36, s36, 0
  s_lshl_b32 s60, s36, 7
  s_and_b32 s60, s60, 0x80
  s_xor_b32 s60, s60, s96
  s_lshl_b32 s61, s36, 6
  s_and_b32 s61, s61, 0x80
  s_xor_b32 s61, s61, s97
  s_lshl_b32 s62, s36, 5
  s_and_b32 s62, s62, 0x80
  s_xor_b32 s62, s62, s98
  s_lshl_b32 s63, s36, 4
  s_and_b32 s63, s63, 0x80
  s_xor_b32 s63, s63, s99
  s_waitcnt vmcnt(0)
  ds_read_b64_tr_b16 v[64:65], v4 offset:0
  ds_read_b64_tr_b16 v[66:67], v4 offset:2048
  ds_read_b64_tr_b16 v[68:69], v4 offset:4096
  ds_read_b64_tr_b16 v[70:71], v4 offset:6144
  ds_read_b64_tr_b16 v[72:73], v4 offset:8192
  ds_read_b64_tr_b16 v[74:75], v4 offset:10240
  ds_read_b64_tr_b16 v[76:77], v4 offset:12288
  ds_read_b64_tr_b16 v[78:79], v4 offset:14336
  ds_read_b64_tr_b16 v[80:81], v4 offset:32
  ds_read_b64_tr_b16 v[82:83], v4 offset:2080
  ds_read_b64_tr_b16 v[84:85], v4 offset:4128
  ds_read_b64_tr_b16 v[86:87], v4 offset:6176
  ds_read_b64_tr_b16 v[88:89], v4 offset:8224
  ds_read_b64_tr_b16 v[90:91], v4 offset:10272
  ds_read_b64_tr_b16 v[92:93], v4 offset:12320
  ds_read_b64_tr_b16 v[94:95], v4 offset:14368
  ds_read_b64_tr_b16 v[96:97], v4 offset:64
  ds_read_b64_tr_b16 v[98:99], v4 offset:2112
  ds_read_b64_tr_b16 v[100:101], v4 offset:4160
  ds_read_b64_tr_b16 v[102:103], v4 offset:6208
  ds_read_b64_tr_b16 v[104:105], v4 offset:8256
  ds_read_b64_tr_b16 v[106:107], v4 offset:10304
  ds_read_b64_tr_b16 v[108:109], v4 offset:12352
  ds_read_b64_tr_b16 v[110:111], v4 offset:14400
  ds_read_b64_tr_b16 v[112:113], v4 offset:96
  ds_read_b64_tr_b16 v[114:115], v4 offset:2144
  ds_read_b64_tr_b16 v[116:117], v4 offset:4192
  ds_read_b64_tr_b16 v[118:119], v4 offset:6240
  ds_read_b64_tr_b16 v[120:121], v4 offset:8288
  ds_read_b64_tr_b16 v[122:123], v4 offset:10336
  ds_read_b64_tr_b16 v[124:125], v4 offset:12384
  ds_read_b64_tr_b16 v[126:127], v4 offset:14432
L_xnw:
  ds_read_b32 v9, v19 offset:24
  s_waitcnt lgkmcnt(0)
  v_cmp_eq_u32 vcc, 0, v9
  s_cbranch_vccz L_xnwok
  s_sleep 1
  s_sub_u32 s15, s15, 1
  s_cbranch_scc0 L_xnw
  s_mov_b32 s15, 0
L_xnwok:
  ds_read2_b64 v[32:35], v6 offset0:0 offset1:4
  ds_read2_b64 v[36:39], v6 offset0:8 offset1:12
  ds_read2_b64 v[40:43], v6 offset0:16 offset1:20
  ds_read2_b64 v[44:47], v6 offset0:24 offset1:28
  s_waitcnt lgkmcnt(3)
  v_mfma_f32_16x16x32_bf16 v[48:51], v[32:35], v[64:67], 0
  v_mfma_f32_16x16x32_bf16 v[52:55], v[32:35], v[80:83], 0
  v_mfma_f32_16x16x32_bf16 v[56:59], v[32:35], v[96:99], 0
  v_mfma_f32_16x16x32_bf16 v[60:63], v[32:35], v[112:115], 0
  s_waitcnt lgkmcnt(2)
  v_mfma_f32_16x16x32_bf16 v[48:51], v[36:39], v[68:71], v[48:51]
  v_mfma_f32_16x16x32_bf16 v[52:55], v[36:39], v[84:87], v[52:55]
  v_mfma_f32_16x16x32_bf16 v[56:59], v[36:39], v[100:103], v[56:59]
  v_mfma_f32_16x16x32_bf16 v[60:63], v[36:39], v[116:119], v[60:63]
  s_waitcnt lgkmcnt(1)
  v_mfma_f32_16x16x32_bf16 v[48:51], v[40:43], v[72:75], v[48:51]
  v_mfma_f32_16x16x32_bf16 v[52:55], v[40:43], v[88:91], v[52:55]
  v_mfma_f32_16x16x32_bf16 v[56:59], v[40:43], v[104:107], v[56:59]
  v_mfma_f32_16x16x32_bf16 v[60:63], v[40:43], v[120:123], v[60:63]
  s_waitcnt lgkmcnt(0)
  v_mfma_f32_16x16x32_bf16 v[48:51], v[44:47], v[76:79], v[48:51]
  v_mfma_f32_16x16x32_bf16 v[52:55], v[44:47], v[92:95], v[52:55]
  v_mfma_f32_16x16x32_bf16 v[56:59], v[44:47], v[108:111], v[56:59]
  v_mfma_f32_16x16x32_bf16 v[60:63], v[44:47], v[124:127], v[60:63]
  s_nop 4
  v_add_u32 v12, 0x80, v48
  v_add_u32 v13, 0x80, v52
  v_add_u32 v14, 0x80, v56
  v_add_u32 v15, 0x80, v60
  v_and_or_b32 v12, v12, v29, s60
  v_and_or_b32 v13, v13, v29, s61
  v_and_or_b32 v14, v14, v29, s62
  v_and_or_b32 v15, v15, v29, s63
  global_store_dwordx4 v7, v[12:15], s[58:59]
  ds_write_b32 v10, v11
  s_mov_b32 s100, 1
  s_branch L_kpart
L_codeend:

.section .rodata,"a"
.p2align 6
.amdhsa_kernel parallel_sum__gqa_block_cached__glu_gated_bilinear__decode_kernel
  .amdhsa_next_free_vgpr 128
  .amdhsa_next_free_sgpr 102
  .amdhsa_accum_offset 128
  .amdhsa_group_segment_fixed_size 0
  .amdhsa_kernarg_size 96
  .amdhsa_user_sgpr_count 2
  .amdhsa_user_sgpr_kernarg_segment_ptr 1
  .amdhsa_system_sgpr_workgroup_id_x 1
  .amdhsa_float_denorm_mode_32 3
.end_amdhsa_kernel
```
